```python
import torch

def _softmax(x, axis=-1):
    return torch.softmax(x, dim=axis)
def _gelu(x):
    return torch.nn.functional.gelu(x, approximate="tanh")
def _silu(x):
    return torch.nn.functional.silu(x)
def _sigmoid(x):
    return torch.sigmoid(x)
def _layernorm(x, axis=-1, eps=1e-5):
    m = x.mean(dim=axis, keepdim=True)
    v = x.var(dim=axis, keepdim=True, unbiased=False)
    return (x - m) / torch.sqrt(v + eps)
def _scatter_add(tgt, idx, src, axis=0):
    return tgt.clone().index_add_(axis, idx, src)
def _segment_sum(src, seg, n):
    out = torch.zeros((n,) + src.shape[1:], dtype=src.dtype)
    return out.index_add_(0, seg, src)
def _pad(x, pw):
    flat = tuple(v for pair in reversed(pw) for v in pair)
    return torch.nn.functional.pad(x, flat)

kernel_name = 'standalone__instancenorm__prompt'

def setup_inputs():

    _w = (lambda a: (lambda t: t.to(torch.bfloat16) if t.is_floating_point() else t)(torch.as_tensor(a)))
    B, C, H, W = 1, 448, 2048, 16
    return {
        "x": _w(abs((lambda *s: torch.randn(*s, dtype=torch.bfloat16) * 0.05)(B, C, H, W))),
        "g": _w((lambda *s: torch.randn(*s, dtype=torch.bfloat16) * 0.05)(C) + 1.0),
        "b": _w((lambda *s: torch.randn(*s, dtype=torch.bfloat16) * 0.4)(C)),
    }

def reference(x, g, b):
    mu = x.mean(axis=(-2, -1), keepdims=True)
    var = ((x - mu) ** 2).mean(axis=(-2, -1), keepdims=True)
    xhat = (x - mu) / torch.sqrt(var + 1e-5)
    return xhat * g.reshape(1, -1, 1, 1) + b.reshape(1, -1, 1, 1)
```

```asm
; @launch grid=(256,1,1) block=(512,1,1) lds=256
.amdgcn_target "amdgcn-amd-amdhsa--gfx950"
.text
.globl standalone__instancenorm__prompt_kernel
.p2align 8
.type standalone__instancenorm__prompt_kernel,@function
standalone__instancenorm__prompt_kernel:
    s_load_dwordx2 s[16:17], s[0:1], 0
    s_load_dwordx4 s[4:7], s[0:1], 8
    s_load_dwordx2 s[20:21], s[0:1], 24
    s_cmp_ge_u32 s2, 256
    s_cbranch_scc1 L_end
    v_lshrrev_b32 v2, 6, v0
    v_and_b32 v3, 63, v0
    s_add_u32 s13, s2, 256
    v_readfirstlane_b32 s28, v2
    v_lshlrev_b32 v1, 4, v3
    v_lshl_add_u32 v1, v2, 13, v1
    s_lshl_b32 s24, s2, 16
    s_min_u32 s15, s13, 447
    s_lshl_b32 s25, s15, 16
    s_add_u32 s26, s24, 4096
    s_add_u32 s27, s25, 4096
    s_mov_b32 s18, 29360128
    s_mov_b32 s19, 0x20000
    s_mov_b32 s22, s18
    s_mov_b32 s23, s19
    s_mov_b32 s11, s19
    s_lshl_b32 s14, s2, 1
    s_lshl_b32 s15, s15, 1
    s_and_b32 s14, s14, -4
    s_and_b32 s15, s15, -4
    s_cmp_ge_u32 s13, 448
    s_cselect_b32 s10, 0, s18
    s_cselect_b32 s29, 3, 0
    s_cmp_lt_u32 s28, 2
    s_waitcnt lgkmcnt(0)
    buffer_load_dwordx4 v[24:27], v1, s[16:19], s24 offen offset:0 nt
    buffer_load_dwordx4 v[28:31], v1, s[16:19], s24 offen offset:1024 nt
    buffer_load_dwordx4 v[32:35], v1, s[16:19], s24 offen offset:2048 nt
    buffer_load_dwordx4 v[36:39], v1, s[16:19], s24 offen offset:3072 nt
    buffer_load_dwordx4 v[40:43], v1, s[16:19], s26 offen offset:0 nt
    buffer_load_dwordx4 v[44:47], v1, s[16:19], s26 offen offset:1024 nt
    buffer_load_dwordx4 v[48:51], v1, s[16:19], s26 offen offset:2048 nt
    buffer_load_dwordx4 v[52:55], v1, s[16:19], s26 offen offset:3072 nt
    s_mov_b64 s[8:9], s[16:17]
    s_load_dword s30, s[16:17], s24
    s_load_dword s31, s[4:5], s14
    s_load_dword s32, s[6:7], s14
    s_load_dword s33, s[16:17], s25
    s_load_dword s34, s[4:5], s15
    s_load_dword s35, s[6:7], s15
    s_cbranch_scc1 L_ldb
    s_barrier
L_ldb:
    buffer_load_dwordx4 v[56:59], v1, s[8:11], s25 offen offset:0 nt
    buffer_load_dwordx4 v[60:63], v1, s[8:11], s25 offen offset:1024 nt
    buffer_load_dwordx4 v[64:67], v1, s[8:11], s25 offen offset:2048 nt
    buffer_load_dwordx4 v[68:71], v1, s[8:11], s25 offen offset:3072 nt
    buffer_load_dwordx4 v[72:75], v1, s[8:11], s27 offen offset:0 nt
    buffer_load_dwordx4 v[76:79], v1, s[8:11], s27 offen offset:1024 nt
    buffer_load_dwordx4 v[80:83], v1, s[8:11], s27 offen offset:2048 nt
    buffer_load_dwordx4 v[84:87], v1, s[8:11], s27 offen offset:3072 nt
    s_cbranch_scc0 L_ldc
    s_barrier
L_ldc:
    s_mov_b32 s36, 0x3f803f80
    s_mov_b32 s37, 0xffff0000
    s_bitcmp1_b32 s2, 0
    s_cselect_b32 s14, 0, 16
    v_lshrrev_b32 v14, 5, v3
    v_lshl_add_u32 v2, v2, 1, v14
    v_lshlrev_b32 v2, 2, v2
    v_and_b32 v3, 7, v3
    v_lshlrev_b32 v3, 3, v3
L_loop:
    v_mov_b32 v4, 0
    v_mov_b32 v6, 0
    s_waitcnt vmcnt(15)
    v_dot2c_f32_bf16 v4, s36, v24
    v_dot2c_f32_bf16 v6, v24, v24
    v_dot2c_f32_bf16 v4, s36, v25
    v_dot2c_f32_bf16 v6, v25, v25
    v_dot2c_f32_bf16 v4, s36, v26
    v_dot2c_f32_bf16 v6, v26, v26
    v_dot2c_f32_bf16 v4, s36, v27
    v_dot2c_f32_bf16 v6, v27, v27
    s_waitcnt vmcnt(14)
    v_dot2c_f32_bf16 v4, s36, v28
    v_dot2c_f32_bf16 v6, v28, v28
    v_dot2c_f32_bf16 v4, s36, v29
    v_dot2c_f32_bf16 v6, v29, v29
    v_dot2c_f32_bf16 v4, s36, v30
    v_dot2c_f32_bf16 v6, v30, v30
    v_dot2c_f32_bf16 v4, s36, v31
    v_dot2c_f32_bf16 v6, v31, v31
    s_waitcnt vmcnt(13)
    v_dot2c_f32_bf16 v4, s36, v32
    v_dot2c_f32_bf16 v6, v32, v32
    v_dot2c_f32_bf16 v4, s36, v33
    v_dot2c_f32_bf16 v6, v33, v33
    v_dot2c_f32_bf16 v4, s36, v34
    v_dot2c_f32_bf16 v6, v34, v34
    v_dot2c_f32_bf16 v4, s36, v35
    v_dot2c_f32_bf16 v6, v35, v35
    s_waitcnt vmcnt(12)
    v_dot2c_f32_bf16 v4, s36, v36
    v_dot2c_f32_bf16 v6, v36, v36
    v_dot2c_f32_bf16 v4, s36, v37
    v_dot2c_f32_bf16 v6, v37, v37
    v_dot2c_f32_bf16 v4, s36, v38
    v_dot2c_f32_bf16 v6, v38, v38
    v_dot2c_f32_bf16 v4, s36, v39
    v_dot2c_f32_bf16 v6, v39, v39
    s_waitcnt vmcnt(11)
    v_dot2c_f32_bf16 v4, s36, v40
    v_dot2c_f32_bf16 v6, v40, v40
    v_dot2c_f32_bf16 v4, s36, v41
    v_dot2c_f32_bf16 v6, v41, v41
    v_dot2c_f32_bf16 v4, s36, v42
    v_dot2c_f32_bf16 v6, v42, v42
    v_dot2c_f32_bf16 v4, s36, v43
    v_dot2c_f32_bf16 v6, v43, v43
    s_waitcnt vmcnt(10)
    v_dot2c_f32_bf16 v4, s36, v44
    v_dot2c_f32_bf16 v6, v44, v44
    v_dot2c_f32_bf16 v4, s36, v45
    v_dot2c_f32_bf16 v6, v45, v45
    v_dot2c_f32_bf16 v4, s36, v46
    v_dot2c_f32_bf16 v6, v46, v46
    v_dot2c_f32_bf16 v4, s36, v47
    v_dot2c_f32_bf16 v6, v47, v47
    s_waitcnt vmcnt(9)
    v_dot2c_f32_bf16 v4, s36, v48
    v_dot2c_f32_bf16 v6, v48, v48
    v_dot2c_f32_bf16 v4, s36, v49
    v_dot2c_f32_bf16 v6, v49, v49
    v_dot2c_f32_bf16 v4, s36, v50
    v_dot2c_f32_bf16 v6, v50, v50
    v_dot2c_f32_bf16 v4, s36, v51
    v_dot2c_f32_bf16 v6, v51, v51
    s_waitcnt lgkmcnt(0)
    s_and_b32 s30, s30, s37
    s_lshl_b32 s31, s31, s14
    s_lshl_b32 s32, s32, s14
    s_and_b32 s31, s31, s37
    s_and_b32 s32, s32, s37
    v_mov_b32 v8, s30
    v_mul_f32 v9, 0x42800000, v8
    s_waitcnt vmcnt(8)
    v_dot2c_f32_bf16 v4, s36, v52
    v_dot2c_f32_bf16 v6, v52, v52
    v_dot2c_f32_bf16 v4, s36, v53
    v_dot2c_f32_bf16 v6, v53, v53
    v_dot2c_f32_bf16 v4, s36, v54
    v_dot2c_f32_bf16 v6, v54, v54
    v_dot2c_f32_bf16 v4, s36, v55
    v_dot2c_f32_bf16 v6, v55, v55
    s_nop 1
    v_sub_f32 v5, v4, v9
    v_add_f32 v4, v4, v5
    v_fma_f32 v6, -v8, v4, v6
    s_nop 1
    v_permlane32_swap_b32 v5, v6
    v_add_f32 v4, v5, v6
    s_nop 1
    v_add_f32_dpp v4, v4, v4 quad_perm:[1,0,3,2] row_mask:0xf bank_mask:0xf
    s_nop 1
    v_add_f32_dpp v4, v4, v4 quad_perm:[2,3,0,1] row_mask:0xf bank_mask:0xf
    s_nop 1
    v_add_f32_dpp v4, v4, v4 row_half_mirror row_mask:0xf bank_mask:0xf
    s_nop 1
    v_add_f32_dpp v4, v4, v4 row_mirror row_mask:0xf bank_mask:0xf
    s_nop 1
    v_add_f32_dpp v4, v4, v4 row_bcast:15 row_mask:0xa bank_mask:0xf
    s_mov_b32 exec_lo, 0x80000000
    s_mov_b32 exec_hi, 0x80000000
    ds_write_b32 v2, v4
    s_mov_b64 exec, -1
    s_waitcnt lgkmcnt(0)
    s_barrier
    ds_read_b64 v[4:5], v3
    s_waitcnt lgkmcnt(0)
    s_nop 0
    v_add_f32_dpp v4, v4, v4 quad_perm:[1,0,3,2] row_mask:0xf bank_mask:0xf
    v_add_f32_dpp v5, v5, v5 quad_perm:[1,0,3,2] row_mask:0xf bank_mask:0xf
    s_nop 0
    v_add_f32_dpp v4, v4, v4 quad_perm:[2,3,0,1] row_mask:0xf bank_mask:0xf
    v_add_f32_dpp v5, v5, v5 quad_perm:[2,3,0,1] row_mask:0xf bank_mask:0xf
    s_nop 0
    v_add_f32_dpp v4, v4, v4 row_half_mirror row_mask:0xf bank_mask:0xf
    v_add_f32_dpp v5, v5, v5 row_half_mirror row_mask:0xf bank_mask:0xf
    v_mul_f32 v4, 0x38000000, v4
    v_mul_f32 v5, 0x38000000, v5
    v_add_f32 v12, v8, v4
    v_cvt_pk_bf16_f32 v12, v12, v12
    v_and_b32 v12, s37, v12
    v_sub_f32 v6, v12, v8
    v_fma_f32 v4, -2.0, v4, v6
    v_fma_f32 v4, v4, v6, v5
    v_cvt_pk_bf16_f32 v4, v4, v4
    v_and_b32 v4, 0x7fff0000, v4
    v_add_f32 v4, 0x3727c5ac, v4
    v_cvt_pk_bf16_f32 v4, v4, v4
    v_and_b32 v4, s37, v4
    v_sqrt_f32 v4, v4
    v_mov_b32 v10, s32
    v_cvt_pk_bf16_f32 v4, v4, v4
    v_and_b32 v4, s37, v4
    v_rcp_f32 v4, v4
    v_xor_b32 v2, 0x80, v2
    v_mul_f32 v8, s31, v4
    v_lshlrev_b32 v14, 16, v24
    v_and_b32 v15, s37, v24
    v_lshlrev_b32 v16, 16, v25
    v_and_b32 v17, s37, v25
    v_lshlrev_b32 v18, 16, v26
    v_and_b32 v19, s37, v26
    v_lshlrev_b32 v20, 16, v27
    v_and_b32 v21, s37, v27
    v_pk_add_f32 v[14:15], v[14:15], v[12:13] op_sel_hi:[1,0] neg_lo:[0,1] neg_hi:[0,1]
    v_pk_add_f32 v[16:17], v[16:17], v[12:13] op_sel_hi:[1,0] neg_lo:[0,1] neg_hi:[0,1]
    v_pk_add_f32 v[18:19], v[18:19], v[12:13] op_sel_hi:[1,0] neg_lo:[0,1] neg_hi:[0,1]
    v_pk_add_f32 v[20:21], v[20:21], v[12:13] op_sel_hi:[1,0] neg_lo:[0,1] neg_hi:[0,1]
    v_pk_fma_f32 v[14:15], v[14:15], v[8:9], v[10:11] op_sel_hi:[1,0,0]
    v_pk_fma_f32 v[16:17], v[16:17], v[8:9], v[10:11] op_sel_hi:[1,0,0]
    v_pk_fma_f32 v[18:19], v[18:19], v[8:9], v[10:11] op_sel_hi:[1,0,0]
    v_pk_fma_f32 v[20:21], v[20:21], v[8:9], v[10:11] op_sel_hi:[1,0,0]
    v_cvt_pk_bf16_f32 v24, v14, v15
    v_cvt_pk_bf16_f32 v25, v16, v17
    v_cvt_pk_bf16_f32 v26, v18, v19
    v_cvt_pk_bf16_f32 v27, v20, v21
    v_lshlrev_b32 v14, 16, v28
    v_and_b32 v15, s37, v28
    v_lshlrev_b32 v16, 16, v29
    v_and_b32 v17, s37, v29
    v_lshlrev_b32 v18, 16, v30
    v_and_b32 v19, s37, v30
    v_lshlrev_b32 v20, 16, v31
    v_and_b32 v21, s37, v31
    v_pk_add_f32 v[14:15], v[14:15], v[12:13] op_sel_hi:[1,0] neg_lo:[0,1] neg_hi:[0,1]
    v_pk_add_f32 v[16:17], v[16:17], v[12:13] op_sel_hi:[1,0] neg_lo:[0,1] neg_hi:[0,1]
    v_pk_add_f32 v[18:19], v[18:19], v[12:13] op_sel_hi:[1,0] neg_lo:[0,1] neg_hi:[0,1]
    v_pk_add_f32 v[20:21], v[20:21], v[12:13] op_sel_hi:[1,0] neg_lo:[0,1] neg_hi:[0,1]
    v_pk_fma_f32 v[14:15], v[14:15], v[8:9], v[10:11] op_sel_hi:[1,0,0]
    v_pk_fma_f32 v[16:17], v[16:17], v[8:9], v[10:11] op_sel_hi:[1,0,0]
    v_pk_fma_f32 v[18:19], v[18:19], v[8:9], v[10:11] op_sel_hi:[1,0,0]
    v_pk_fma_f32 v[20:21], v[20:21], v[8:9], v[10:11] op_sel_hi:[1,0,0]
    v_cvt_pk_bf16_f32 v28, v14, v15
    v_cvt_pk_bf16_f32 v29, v16, v17
    v_cvt_pk_bf16_f32 v30, v18, v19
    v_cvt_pk_bf16_f32 v31, v20, v21
    v_lshlrev_b32 v14, 16, v32
    v_and_b32 v15, s37, v32
    v_lshlrev_b32 v16, 16, v33
    v_and_b32 v17, s37, v33
    v_lshlrev_b32 v18, 16, v34
    v_and_b32 v19, s37, v34
    v_lshlrev_b32 v20, 16, v35
    v_and_b32 v21, s37, v35
    v_pk_add_f32 v[14:15], v[14:15], v[12:13] op_sel_hi:[1,0] neg_lo:[0,1] neg_hi:[0,1]
    v_pk_add_f32 v[16:17], v[16:17], v[12:13] op_sel_hi:[1,0] neg_lo:[0,1] neg_hi:[0,1]
    v_pk_add_f32 v[18:19], v[18:19], v[12:13] op_sel_hi:[1,0] neg_lo:[0,1] neg_hi:[0,1]
    v_pk_add_f32 v[20:21], v[20:21], v[12:13] op_sel_hi:[1,0] neg_lo:[0,1] neg_hi:[0,1]
    v_pk_fma_f32 v[14:15], v[14:15], v[8:9], v[10:11] op_sel_hi:[1,0,0]
    v_pk_fma_f32 v[16:17], v[16:17], v[8:9], v[10:11] op_sel_hi:[1,0,0]
    v_pk_fma_f32 v[18:19], v[18:19], v[8:9], v[10:11] op_sel_hi:[1,0,0]
    v_pk_fma_f32 v[20:21], v[20:21], v[8:9], v[10:11] op_sel_hi:[1,0,0]
    v_cvt_pk_bf16_f32 v32, v14, v15
    v_cvt_pk_bf16_f32 v33, v16, v17
    v_cvt_pk_bf16_f32 v34, v18, v19
    v_cvt_pk_bf16_f32 v35, v20, v21
    v_lshlrev_b32 v14, 16, v36
    v_and_b32 v15, s37, v36
    v_lshlrev_b32 v16, 16, v37
    v_and_b32 v17, s37, v37
    v_lshlrev_b32 v18, 16, v38
    v_and_b32 v19, s37, v38
    v_lshlrev_b32 v20, 16, v39
    v_and_b32 v21, s37, v39
    v_pk_add_f32 v[14:15], v[14:15], v[12:13] op_sel_hi:[1,0] neg_lo:[0,1] neg_hi:[0,1]
    v_pk_add_f32 v[16:17], v[16:17], v[12:13] op_sel_hi:[1,0] neg_lo:[0,1] neg_hi:[0,1]
    v_pk_add_f32 v[18:19], v[18:19], v[12:13] op_sel_hi:[1,0] neg_lo:[0,1] neg_hi:[0,1]
    v_pk_add_f32 v[20:21], v[20:21], v[12:13] op_sel_hi:[1,0] neg_lo:[0,1] neg_hi:[0,1]
    v_pk_fma_f32 v[14:15], v[14:15], v[8:9], v[10:11] op_sel_hi:[1,0,0]
    v_pk_fma_f32 v[16:17], v[16:17], v[8:9], v[10:11] op_sel_hi:[1,0,0]
    v_pk_fma_f32 v[18:19], v[18:19], v[8:9], v[10:11] op_sel_hi:[1,0,0]
    v_pk_fma_f32 v[20:21], v[20:21], v[8:9], v[10:11] op_sel_hi:[1,0,0]
    v_cvt_pk_bf16_f32 v36, v14, v15
    v_cvt_pk_bf16_f32 v37, v16, v17
    v_cvt_pk_bf16_f32 v38, v18, v19
    v_cvt_pk_bf16_f32 v39, v20, v21
    v_lshlrev_b32 v14, 16, v40
    v_and_b32 v15, s37, v40
    v_lshlrev_b32 v16, 16, v41
    v_and_b32 v17, s37, v41
    v_lshlrev_b32 v18, 16, v42
    v_and_b32 v19, s37, v42
    v_lshlrev_b32 v20, 16, v43
    v_and_b32 v21, s37, v43
    v_pk_add_f32 v[14:15], v[14:15], v[12:13] op_sel_hi:[1,0] neg_lo:[0,1] neg_hi:[0,1]
    v_pk_add_f32 v[16:17], v[16:17], v[12:13] op_sel_hi:[1,0] neg_lo:[0,1] neg_hi:[0,1]
    v_pk_add_f32 v[18:19], v[18:19], v[12:13] op_sel_hi:[1,0] neg_lo:[0,1] neg_hi:[0,1]
    v_pk_add_f32 v[20:21], v[20:21], v[12:13] op_sel_hi:[1,0] neg_lo:[0,1] neg_hi:[0,1]
    v_pk_fma_f32 v[14:15], v[14:15], v[8:9], v[10:11] op_sel_hi:[1,0,0]
    v_pk_fma_f32 v[16:17], v[16:17], v[8:9], v[10:11] op_sel_hi:[1,0,0]
    v_pk_fma_f32 v[18:19], v[18:19], v[8:9], v[10:11] op_sel_hi:[1,0,0]
    v_pk_fma_f32 v[20:21], v[20:21], v[8:9], v[10:11] op_sel_hi:[1,0,0]
    v_cvt_pk_bf16_f32 v40, v14, v15
    v_cvt_pk_bf16_f32 v41, v16, v17
    v_cvt_pk_bf16_f32 v42, v18, v19
    v_cvt_pk_bf16_f32 v43, v20, v21
    v_lshlrev_b32 v14, 16, v44
    v_and_b32 v15, s37, v44
    v_lshlrev_b32 v16, 16, v45
    v_and_b32 v17, s37, v45
    v_lshlrev_b32 v18, 16, v46
    v_and_b32 v19, s37, v46
    v_lshlrev_b32 v20, 16, v47
    v_and_b32 v21, s37, v47
    v_pk_add_f32 v[14:15], v[14:15], v[12:13] op_sel_hi:[1,0] neg_lo:[0,1] neg_hi:[0,1]
    v_pk_add_f32 v[16:17], v[16:17], v[12:13] op_sel_hi:[1,0] neg_lo:[0,1] neg_hi:[0,1]
    v_pk_add_f32 v[18:19], v[18:19], v[12:13] op_sel_hi:[1,0] neg_lo:[0,1] neg_hi:[0,1]
    v_pk_add_f32 v[20:21], v[20:21], v[12:13] op_sel_hi:[1,0] neg_lo:[0,1] neg_hi:[0,1]
    v_pk_fma_f32 v[14:15], v[14:15], v[8:9], v[10:11] op_sel_hi:[1,0,0]
    v_pk_fma_f32 v[16:17], v[16:17], v[8:9], v[10:11] op_sel_hi:[1,0,0]
    v_pk_fma_f32 v[18:19], v[18:19], v[8:9], v[10:11] op_sel_hi:[1,0,0]
    v_pk_fma_f32 v[20:21], v[20:21], v[8:9], v[10:11] op_sel_hi:[1,0,0]
    v_cvt_pk_bf16_f32 v44, v14, v15
    v_cvt_pk_bf16_f32 v45, v16, v17
    v_cvt_pk_bf16_f32 v46, v18, v19
    v_cvt_pk_bf16_f32 v47, v20, v21
    v_lshlrev_b32 v14, 16, v48
    v_and_b32 v15, s37, v48
    v_lshlrev_b32 v16, 16, v49
    v_and_b32 v17, s37, v49
    v_lshlrev_b32 v18, 16, v50
    v_and_b32 v19, s37, v50
    v_lshlrev_b32 v20, 16, v51
    v_and_b32 v21, s37, v51
    v_pk_add_f32 v[14:15], v[14:15], v[12:13] op_sel_hi:[1,0] neg_lo:[0,1] neg_hi:[0,1]
    v_pk_add_f32 v[16:17], v[16:17], v[12:13] op_sel_hi:[1,0] neg_lo:[0,1] neg_hi:[0,1]
    v_pk_add_f32 v[18:19], v[18:19], v[12:13] op_sel_hi:[1,0] neg_lo:[0,1] neg_hi:[0,1]
    v_pk_add_f32 v[20:21], v[20:21], v[12:13] op_sel_hi:[1,0] neg_lo:[0,1] neg_hi:[0,1]
    v_pk_fma_f32 v[14:15], v[14:15], v[8:9], v[10:11] op_sel_hi:[1,0,0]
    v_pk_fma_f32 v[16:17], v[16:17], v[8:9], v[10:11] op_sel_hi:[1,0,0]
    v_pk_fma_f32 v[18:19], v[18:19], v[8:9], v[10:11] op_sel_hi:[1,0,0]
    v_pk_fma_f32 v[20:21], v[20:21], v[8:9], v[10:11] op_sel_hi:[1,0,0]
    v_cvt_pk_bf16_f32 v48, v14, v15
    v_cvt_pk_bf16_f32 v49, v16, v17
    v_cvt_pk_bf16_f32 v50, v18, v19
    v_cvt_pk_bf16_f32 v51, v20, v21
    v_lshlrev_b32 v14, 16, v52
    v_and_b32 v15, s37, v52
    v_lshlrev_b32 v16, 16, v53
    v_and_b32 v17, s37, v53
    v_lshlrev_b32 v18, 16, v54
    v_and_b32 v19, s37, v54
    v_lshlrev_b32 v20, 16, v55
    v_and_b32 v21, s37, v55
    v_pk_add_f32 v[14:15], v[14:15], v[12:13] op_sel_hi:[1,0] neg_lo:[0,1] neg_hi:[0,1]
    v_pk_add_f32 v[16:17], v[16:17], v[12:13] op_sel_hi:[1,0] neg_lo:[0,1] neg_hi:[0,1]
    v_pk_add_f32 v[18:19], v[18:19], v[12:13] op_sel_hi:[1,0] neg_lo:[0,1] neg_hi:[0,1]
    v_pk_add_f32 v[20:21], v[20:21], v[12:13] op_sel_hi:[1,0] neg_lo:[0,1] neg_hi:[0,1]
    v_pk_fma_f32 v[14:15], v[14:15], v[8:9], v[10:11] op_sel_hi:[1,0,0]
    v_pk_fma_f32 v[16:17], v[16:17], v[8:9], v[10:11] op_sel_hi:[1,0,0]
    v_pk_fma_f32 v[18:19], v[18:19], v[8:9], v[10:11] op_sel_hi:[1,0,0]
    v_pk_fma_f32 v[20:21], v[20:21], v[8:9], v[10:11] op_sel_hi:[1,0,0]
    v_cvt_pk_bf16_f32 v52, v14, v15
    v_cvt_pk_bf16_f32 v53, v16, v17
    v_cvt_pk_bf16_f32 v54, v18, v19
    v_cvt_pk_bf16_f32 v55, v20, v21
    s_cmp_eq_u32 s13, 1000
    s_cbranch_scc1 L_nb
    s_barrier
L_nb:
    s_cmp_lt_u32 s28, s29
    s_cbranch_scc1 L_plain
    buffer_store_dwordx4 v[24:27], v1, s[20:23], s24 offen offset:0 nt
    buffer_store_dwordx4 v[28:31], v1, s[20:23], s24 offen offset:1024 nt
    buffer_store_dwordx4 v[32:35], v1, s[20:23], s24 offen offset:2048 nt
    buffer_store_dwordx4 v[36:39], v1, s[20:23], s24 offen offset:3072 nt
    buffer_store_dwordx4 v[40:43], v1, s[20:23], s26 offen offset:0 nt
    buffer_store_dwordx4 v[44:47], v1, s[20:23], s26 offen offset:1024 nt
    buffer_store_dwordx4 v[48:51], v1, s[20:23], s26 offen offset:2048 nt
    buffer_store_dwordx4 v[52:55], v1, s[20:23], s26 offen offset:3072 nt
    s_cmp_ge_u32 s13, 448
    s_cbranch_scc1 L_fin
    s_movk_i32 s13, 1000
    s_mov_b32 s24, s25
    s_mov_b32 s26, s27
    s_xor_b32 s28, s28, 7
    s_mov_b32 s29, 1
    s_mov_b32 s30, s33
    s_mov_b32 s31, s34
    s_mov_b32 s32, s35
    v_xor_b32 v3, 0x80, v3
    s_waitcnt vmcnt(8)
    v_mov_b64 v[24:25], v[56:57]
    v_mov_b64 v[26:27], v[58:59]
    v_mov_b64 v[28:29], v[60:61]
    v_mov_b64 v[30:31], v[62:63]
    v_mov_b64 v[32:33], v[64:65]
    v_mov_b64 v[34:35], v[66:67]
    v_mov_b64 v[36:37], v[68:69]
    v_mov_b64 v[38:39], v[70:71]
    v_mov_b64 v[40:41], v[72:73]
    v_mov_b64 v[42:43], v[74:75]
    v_mov_b64 v[44:45], v[76:77]
    v_mov_b64 v[46:47], v[78:79]
    v_mov_b64 v[48:49], v[80:81]
    v_mov_b64 v[50:51], v[82:83]
    v_mov_b64 v[52:53], v[84:85]
    v_mov_b64 v[54:55], v[86:87]
    s_branch L_loop
L_plain:
    buffer_store_dwordx4 v[24:27], v1, s[20:23], s24 offen offset:0
    buffer_store_dwordx4 v[28:31], v1, s[20:23], s24 offen offset:1024
    buffer_store_dwordx4 v[32:35], v1, s[20:23], s24 offen offset:2048
    buffer_store_dwordx4 v[36:39], v1, s[20:23], s24 offen offset:3072
    buffer_store_dwordx4 v[40:43], v1, s[20:23], s26 offen offset:0
    buffer_store_dwordx4 v[44:47], v1, s[20:23], s26 offen offset:1024
    buffer_store_dwordx4 v[48:51], v1, s[20:23], s26 offen offset:2048
    buffer_store_dwordx4 v[52:55], v1, s[20:23], s26 offen offset:3072
L_fin:
L_end:
    s_endpgm
.section .rodata,"a"
.p2align 6
.amdhsa_kernel standalone__instancenorm__prompt_kernel
  .amdhsa_next_free_vgpr 88
  .amdhsa_next_free_sgpr 40
  .amdhsa_accum_offset 88
  .amdhsa_group_segment_fixed_size 0
  .amdhsa_kernarg_size 48
  .amdhsa_user_sgpr_count 2
  .amdhsa_user_sgpr_kernarg_segment_ptr 1
  .amdhsa_system_sgpr_workgroup_id_x 1
  .amdhsa_float_denorm_mode_32 3
.end_amdhsa_kernel
```
